```python
import torch

def _softmax(x, axis=-1):
    return torch.softmax(x, dim=axis)
def _gelu(x):
    return torch.nn.functional.gelu(x, approximate="tanh")
def _silu(x):
    return torch.nn.functional.silu(x)
def _sigmoid(x):
    return torch.sigmoid(x)
def _layernorm(x, axis=-1, eps=1e-5):
    m = x.mean(dim=axis, keepdim=True)
    v = x.var(dim=axis, keepdim=True, unbiased=False)
    return (x - m) / torch.sqrt(v + eps)
def _scatter_add(tgt, idx, src, axis=0):
    return tgt.clone().index_add_(axis, idx, src)
def _segment_sum(src, seg, n):
    out = torch.zeros((n,) + src.shape[1:], dtype=src.dtype)
    return out.index_add_(0, seg, src)
def _pad(x, pw):
    flat = tuple(v for pair in reversed(pw) for v in pair)
    return torch.nn.functional.pad(x, flat)

kernel_name = 'recurrent_scan__sliding_block_cached__mixer_token_mlp__decode'

def setup_inputs():

    _w = (lambda a: (lambda t: t.to(torch.bfloat16) if t.is_floating_point() else t)(torch.as_tensor(a)))
    def _A_setup():
        B, Sq, D = 1, 1, 512
        Hq, Hkv, Sk, Dh = 32, 8, 32768, 128
        assert Hq % Hkv == 0, (Hq, Hkv)
        return {
            "x": _w((lambda *s: torch.randn(*s, dtype=torch.bfloat16) * 0.4)(B, Sq, D)),
            "k_cache": _w((lambda *s: torch.randn(*s, dtype=torch.bfloat16) * 1.6)(B, Hkv, Sk, Dh)),
            "v_cache": _w((lambda *s: torch.randn(*s, dtype=torch.bfloat16) * 1.6)(B, Hkv, Sk, Dh)),
            "wq": _w((lambda *s: torch.randn(*s, dtype=torch.bfloat16) * 1.6)(D, Hq * Dh) * (D ** -0.5)),
            "wo": _w((lambda *s: torch.randn(*s, dtype=torch.bfloat16) * 1.6)(Hq * Dh, D) * ((Hq * Dh) ** -0.5)),
        }
    _A_in = _A_setup()

    def _B_setup():
        B, S, D, F = 1, 1, 512, 1792
        return {
            "x": _w((lambda *s: torch.randn(*s, dtype=torch.bfloat16) * 0.4)(B, S, D)),
            "w1": _w((lambda *s: torch.randn(*s, dtype=torch.bfloat16) * 1.6)(S, F) * (S ** -0.5)),
            "b1": _w((lambda *s: torch.randn(*s, dtype=torch.bfloat16) * 1.6)(F) * 0.02),
            "w2": _w((lambda *s: torch.randn(*s, dtype=torch.bfloat16) * 1.6)(F, S) * (F ** -0.5)),
            "b2": _w((lambda *s: torch.randn(*s, dtype=torch.bfloat16) * 1.6)(S) * 0.02),
        }
    _B_in = _B_setup()

    return {
        "A_x": _A_in["x"],
        "A_k_cache": _A_in["k_cache"],
        "A_v_cache": _A_in["v_cache"],
        "A_wq": _A_in["wq"],
        "A_wo": _A_in["wo"],
        "B_x": _B_in["x"],
        "B_w1": _B_in["w1"],
        "B_b1": _B_in["b1"],
        "B_w2": _B_in["w2"],
        "B_b2": _B_in["b2"],
    }

def reference(A_x, A_k_cache, A_v_cache, A_wq, A_wo, B_x, B_w1, B_b1, B_w2, B_b2):
    def _A_ref(x, k_cache, v_cache, wq, wo):
        B, Sq, D = x.shape
        Hq, Dh = 32, 128
        Hkv, Sk = k_cache.shape[1], k_cache.shape[2]
        W = min(4096, max(256, Sk // 4))
        rep = Hq // Hkv
        q = (lambda x, *d: x.permute(*d))((x @ wq).reshape(B, Sq, Hq, Dh), 0, 2, 1, 3)
        k = (lambda x, n, axis: torch.repeat_interleave(x, n, dim=axis))(k_cache[:, :, Sk - W:, :], rep, axis=1)
        v = (lambda x, n, axis: torch.repeat_interleave(x, n, dim=axis))(v_cache[:, :, Sk - W:, :], rep, axis=1)
        scores = torch.einsum("bhqd,bhkd->bhqk", q, k) * (Dh ** -0.5)
        p = _softmax(scores, axis=-1)
        o = torch.einsum("bhqk,bhkd->bhqd", p, v)
        return (lambda x, *d: x.permute(*d))(o, 0, 2, 1, 3).reshape(B, Sq, Hq * Dh) @ wo

    def _B_ref(x, w1, b1, w2, b2):
        B, S, D = x.shape
        h = _layernorm(x, axis=-1)
        u = torch.einsum("bsd,sf->bdf", h, w1) + b1
        u = _gelu(u)
        y = torch.einsum("bdf,fs->bds", u, w2) + b2
        return (lambda x, *d: x.permute(*d))(y, 0, 2, 1)

    x = A_x
    xn = _layernorm(x, axis=-1)
    s = _A_ref(xn, A_k_cache, A_v_cache, A_wq, A_wo)
    g = _silu(_B_ref(xn, B_w1, B_b1, B_w2, B_b2))
    return x + s * g
```

```asm
; @launch grid=(256,1,1) block=(512,1,1) lds=75120
.amdgcn_target "amdgcn-amd-amdhsa--gfx950"
.text
.globl recurrent_scan__sliding_block_cached__mixer_token_mlp__decode_kernel
.p2align 12
.type recurrent_scan__sliding_block_cached__mixer_token_mlp__decode_kernel,@function
recurrent_scan__sliding_block_cached__mixer_token_mlp__decode_kernel:
    s_cmp_ge_u32 s2, 256
    s_cbranch_scc1 L_end
    s_load_dwordx16 s[8:23], s[0:1], 0
    s_load_dwordx8 s[24:31], s[0:1], 64
    s_load_dwordx2 s[32:33], s[0:1], 96
    v_lshrrev_b32 v1, 6, v0
    v_and_b32 v0, 63, v0
    v_readfirstlane_b32 s3, v1
    s_and_b32 s4, s2, 7
    s_lshr_b32 s5, s2, 3
    s_xor_b32 s3, s3, 4
    s_mov_b32 s39, 0x00020000
    s_mov_b32 s43, s39
    v_lshlrev_b32 v3, 4, v0
    s_cmp_ge_u32 s3, 4
    s_cbranch_scc1 L_aux
    s_mov_b32 s0, 0
    s_cmp_lg_u32 s3, 0
    s_cbranch_scc1 L_nocpf
    s_and_b32 s60, s5, 7
    s_cbranch_scc1 L_nocpf
    s_getpc_b64 s[60:61]
L_pc:
    v_lshlrev_b32 v21, 7, v0
    v_min_u32 v21, L_codeend-L_pc-1024-4, v21
    global_load_dword v22, v21, s[60:61] offset:1024
L_nocpf:
    s_mov_b32 s38, 0x4000000
    s_mov_b32 s42, s38
    s_lshl_b32 s70, s4, 23
    s_lshl_b32 s61, s5, 12
    s_add_u32 s70, s70, s61
    s_add_u32 s70, s70, 7340032
    s_lshl_b32 s75, s3, 10
    s_add_u32 s72, s70, s75
    s_lshl_b32 s73, s3, 13
    s_lshl_b32 s61, s3, 18
    s_add_u32 s70, s70, s61
    s_xor_b32 s70, s70, s73
    s_xor_b32 s71, s70, 0x21000
    v_and_b32 v2, 15, v0
    v_lshrrev_b32 v1, 4, v0
    v_xor_b32 v7, v2, v1
    v_lshlrev_b32 v16, 8, v1
    v_lshl_add_u32 v16, v7, 4, v16
    v_xor_b32 v17, 64, v16
    v_xor_b32 v18, 128, v16
    v_xor_b32 v19, 192, v16
    s_mov_b32 m0, s73
    s_barrier
    s_mov_b64 exec, 0
    s_cmp_eq_u32 s3, 0
    s_cbranch_scc1 L_padM0
    s_cmp_eq_u32 s3, 1
    s_cbranch_scc1 L_padM1
    s_cmp_eq_u32 s3, 2
    s_cbranch_scc1 L_padM2
    s_branch L_padM3
L_retM:
    s_mov_b64 exec, -1
    s_cmp_eq_u32 s0, 0
    s_cbranch_scc0 L_end
    s_waitcnt lgkmcnt(0)
    s_mov_b64 s[36:37], s[10:11]
    s_load_dword s56, s[32:33], 0
    s_mov_b64 exec, 0
    s_cmp_eq_u32 s3, 0
    s_cbranch_scc1 L_padN0
    s_cmp_eq_u32 s3, 1
    s_cbranch_scc1 L_padN1
    s_cmp_eq_u32 s3, 2
    s_cbranch_scc1 L_padN2
    s_branch L_padN3
L_aux:
    s_mov_b32 s0, 1
    s_sub_u32 s64, s3, 4
    s_lshr_b32 s6, s5, 3
    s_and_b32 s7, s5, 7
    s_movk_i32 s38, 1024
    s_mov_b32 s42, 0x400000
    v_lshrrev_b32 v5, 3, v0
    v_and_b32 v6, 7, v0
    v_lshlrev_b32 v4, 15, v5
    v_lshl_add_u32 v4, v6, 4, v4
    s_lshl_b32 s70, s6, 20
    s_lshl_b32 s61, s4, 10
    s_add_u32 s70, s70, s61
    s_lshl_b32 s61, s7, 7
    s_add_u32 s70, s70, s61
    s_lshl_b32 s61, s64, 18
    s_add_u32 s70, s70, s61
    s_add_u32 s71, s70, 0x2000
    s_add_u32 s72, s70, 0x4000
    s_add_u32 s73, s70, 0x6000
    v_lshlrev_b32 v12, 2, v0
    v_add_u32 v12, 71792, v12
    v_mov_b32 v9, 0
    ds_write_b32 v12, v9
    s_waitcnt lgkmcnt(0)
    s_mov_b64 s[36:37], s[8:9]
    s_mov_b64 s[40:41], s[14:15]
    buffer_load_dwordx4 v[16:19], v3, s[36:39], 0 offen
    s_load_dword s56, s[32:33], 0
    s_barrier
    buffer_load_dwordx4 v[32:35], v4, s[40:43], s70 offen nt
    buffer_load_dwordx4 v[36:39], v4, s[40:43], s71 offen nt
    buffer_load_dwordx4 v[40:43], v4, s[40:43], s72 offen nt
    buffer_load_dwordx4 v[44:47], v4, s[40:43], s73 offen nt
    s_lshl_b32 s69, s4, 7
    s_lshl_b32 s61, s5, 2
    s_add_u32 s69, s69, s61
    s_mul_i32 s66, s5, 112
    s_mul_i32 s61, s64, 28
    s_add_u32 s66, s66, s61
    s_add_u32 s60, s8, s69
    s_addc_u32 s61, s9, 0
    v_mov_b32 v88, s20
    v_mov_b32 v89, s21
    s_mov_b64 exec, 0xff00
    v_mov_b32 v88, s22
    v_mov_b32 v89, s23
    s_mov_b64 exec, 0xff0000
    v_mov_b32 v88, s24
    v_mov_b32 v89, s25
    s_mov_b64 exec, -1
    v_lshl_add_u32 v90, v6, 2, s66
    v_add_co_u32 v88, vcc, v88, v90
    s_nop 1
    v_addc_co_u32 v89, vcc, 0, v89, vcc
    v_writelane_b32 v88, s60, 24
    v_writelane_b32 v89, s61, 24
    v_writelane_b32 v88, s26, 25
    v_writelane_b32 v89, s27, 25
    s_lshl_b32 s74, s4, 13
    s_lshl_b32 s63, s5, 8
    s_add_u32 s74, s74, s63
    s_add_u32 s74, s74, 65536
    s_lshl_b32 s63, s64, 6
    s_add_u32 s63, s63, s74
    s_add_u32 s60, s32, s63
    s_addc_u32 s61, s33, 0
    v_writelane_b32 v88, s60, 27
    v_writelane_b32 v89, s61, 27
    s_mov_b64 exec, 0x0b7f7f7f
    global_load_dword v91, v[88:89], off
    s_mov_b64 exec, -1
    s_mov_b32 s54, 0x10000000
    s_mov_b32 s55, s39
    s_movk_i32 s59, 0x3ff
    s_mov_b32 s34, 0xffff0000
    s_mov_b64 s[52:53], s[32:33]
    s_mov_b32 s35, 0x3b000000
    s_lshl_b32 s70, s4, 13
    s_add_u32 s70, s70, 65536
    s_add_u32 s75, s74, 65536
    s_lshl_b32 s61, s64, 9
    s_add_u32 s70, s70, s61
    s_getreg_b32 s73, hwreg(HW_REG_XCC_ID)
    s_and_b32 s73, s73, 7
    s_lshl_b32 s73, s73, 7
    v_and_b32 v8, 1, v0
    v_cmp_eq_u32 vcc, 1, v8
    v_mov_b32 v9, 0x0c0c0100
    v_mov_b32 v10, 0x01000c0c
    v_cndmask_b32 v9, v9, v10, vcc
    v_mov_b32 v8, 0x0202
    v_mov_b32 v10, 0x02020000
    v_cndmask_b32 v10, v8, v10, vcc
    v_add_u32 v10, v9, v10
    v_bfe_u32 v8, v0, 1, 2
    v_mov_b32 v13, 0x0c0c0c0c
    v_cmp_eq_u32 vcc, 0, v8
    v_lshlrev_b32 v12, 8, v6
    v_bfe_u32 v14, v0, 4, 1
    v_cndmask_b32 v64, v13, v9, vcc
    v_cndmask_b32 v65, v13, v10, vcc
    v_cmp_eq_u32 vcc, 1, v8
    v_lshl_add_u32 v12, v14, 7, v12
    v_lshrrev_b32 v14, 5, v0
    v_cndmask_b32 v66, v13, v9, vcc
    v_cndmask_b32 v67, v13, v10, vcc
    v_cmp_eq_u32 vcc, 2, v8
    v_lshl_add_u32 v12, v14, 4, v12
    v_lshlrev_b32 v4, 11, v14
    v_cndmask_b32 v68, v13, v9, vcc
    v_cndmask_b32 v69, v13, v10, vcc
    v_cmp_eq_u32 vcc, 3, v8
    v_and_b32 v31, 31, v0
    v_lshl_add_u32 v4, v31, 4, v4
    v_cndmask_b32 v70, v13, v9, vcc
    v_cndmask_b32 v71, v13, v10, vcc
    s_lshl_b32 s61, s64, 5
    s_add_u32 s61, s61, 72048
    v_add_u32 v12, s61, v12
    s_mov_b32 s76, 0x00ff00ff
    s_mov_b32 s77, 0xff00ff00
    v_lshlrev_b32 v87, 3, v31
    v_lshl_add_u32 v87, v14, 2, v87
    s_lshl_b32 s61, s64, 8
    s_add_u32 s61, s61, 65536
L_padM0:
    s_cbranch_execz L_retM
    v_add_u32 v87, s61, v87
    v_lshrrev_b32 v14, 2, v0
    v_and_b32 v8, 3, v0
    v_lshlrev_b32 v13, 7, v14
    v_lshl_add_u32 v13, v8, 4, v13
    v_add_u32 v13, 72048, v13
    v_lshlrev_b32 v14, 4, v14
    v_add_u32 v97, 4096, v4
    v_mov_b32 v80, 71968
    v_mov_b32 v81, 1
    s_lshl_b32 s61, s64, 10
    s_add_u32 s61, s61, 67584
    v_add_u32 v82, s61, v3
    s_lshl_b32 s62, s6, 8
    s_add_u32 s62, s62, s61
    s_lshl_b32 s63, s64, 6
    s_add_u32 s62, s62, s63
    v_lshl_add_u32 v83, v5, 3, s62
    s_lshl_b32 s62, s4, 7
    s_add_u32 s62, s62, s61
    v_lshl_add_u32 v84, v0, 1, s62
    s_waitcnt vmcnt(5)
    v_lshlrev_b32 v20, 16, v16
    v_and_b32 v21, s34, v16
    v_lshlrev_b32 v22, 16, v17
    v_and_b32 v23, s34, v17
    v_lshlrev_b32 v24, 16, v18
    v_and_b32 v25, s34, v18
    v_lshlrev_b32 v26, 16, v19
    v_and_b32 v27, s34, v19
    v_add_f32 v8, v20, v21
    v_add_f32 v9, v22, v23
    v_add_f32 v8, v8, v24
    v_add_f32 v9, v9, v25
    v_add_f32 v8, v8, v26
    v_add_f32 v9, v9, v27
    v_add_f32 v8, v8, v9
    s_nop 1
    v_add_f32_dpp v8, v8, v8 quad_perm:[1,0,3,2] row_mask:0xf bank_mask:0xf
    s_nop 1
    v_add_f32_dpp v8, v8, v8 quad_perm:[2,3,0,1] row_mask:0xf bank_mask:0xf
    s_nop 1
    v_add_f32_dpp v8, v8, v8 row_half_mirror row_mask:0xf bank_mask:0xf
    s_nop 1
    v_add_f32_dpp v8, v8, v8 row_mirror row_mask:0xf bank_mask:0xf
    s_nop 1
    v_add_f32_dpp v8, v8, v8 row_bcast:15 row_mask:0xa bank_mask:0xf
    s_nop 1
    v_add_f32_dpp v8, v8, v8 row_bcast:31 row_mask:0xc bank_mask:0xf
    v_mul_f32 v8, s35, v8
    s_nop 0
    v_readlane_b32 s61, v8, 63
    v_cvt_pk_bf16_f32 v8, v8, v8
    v_lshlrev_b32 v8, 16, v8
    s_nop 0
    v_readlane_b32 s18, v8, 63
    v_subrev_f32 v9, s61, v20
    v_subrev_f32 v10, s61, v21
    v_mul_f32 v8, v9, v9
    v_mul_f32 v11, v10, v10
    v_subrev_f32 v9, s61, v22
    v_subrev_f32 v10, s61, v23
    v_fmac_f32 v8, v9, v9
    v_fmac_f32 v11, v10, v10
    v_subrev_f32 v9, s61, v24
    v_subrev_f32 v10, s61, v25
    v_fmac_f32 v8, v9, v9
    v_fmac_f32 v11, v10, v10
    v_subrev_f32 v9, s61, v26
    v_subrev_f32 v10, s61, v27
    v_fmac_f32 v8, v9, v9
    v_fmac_f32 v11, v10, v10
    v_add_f32 v8, v8, v11
    s_nop 1
    v_add_f32_dpp v8, v8, v8 quad_perm:[1,0,3,2] row_mask:0xf bank_mask:0xf
    s_nop 1
    v_add_f32_dpp v8, v8, v8 quad_perm:[2,3,0,1] row_mask:0xf bank_mask:0xf
    s_nop 1
    v_add_f32_dpp v8, v8, v8 row_half_mirror row_mask:0xf bank_mask:0xf
    s_nop 1
    v_add_f32_dpp v8, v8, v8 row_mirror row_mask:0xf bank_mask:0xf
    s_nop 1
    v_add_f32_dpp v8, v8, v8 row_bcast:15 row_mask:0xa bank_mask:0xf
    s_nop 1
    v_add_f32_dpp v8, v8, v8 row_bcast:31 row_mask:0xc bank_mask:0xf
    v_mul_f32 v8, s35, v8
    v_cvt_pk_bf16_f32 v8, v8, v8
    v_lshlrev_b32 v8, 16, v8
    v_add_f32 v8, 0x3727c5ac, v8
    v_cvt_pk_bf16_f32 v8, v8, v8
    v_lshlrev_b32 v8, 16, v8
    v_sqrt_f32 v8, v8
    s_nop 0
    v_cvt_pk_bf16_f32 v8, v8, v8
    v_lshlrev_b32 v8, 16, v8
    v_rcp_f32 v8, v8
    s_nop 0
    v_readlane_b32 s19, v8, 63
    v_subrev_f32 v20, s18, v20
    v_subrev_f32 v21, s18, v21
    v_subrev_f32 v22, s18, v22
    v_subrev_f32 v23, s18, v23
    v_subrev_f32 v24, s18, v24
    v_subrev_f32 v25, s18, v25
    v_subrev_f32 v26, s18, v26
    v_subrev_f32 v27, s18, v27
    v_cvt_pk_bf16_f32 v16, v20, v21
    v_cvt_pk_bf16_f32 v17, v22, v23
    v_cvt_pk_bf16_f32 v18, v24, v25
    v_cvt_pk_bf16_f32 v19, v26, v27
    v_lshlrev_b32 v20, 16, v16
    v_and_b32 v21, s34, v16
    v_lshlrev_b32 v22, 16, v17
    v_and_b32 v23, s34, v17
    v_lshlrev_b32 v24, 16, v18
    v_and_b32 v25, s34, v18
    v_lshlrev_b32 v26, 16, v19
    v_and_b32 v27, s34, v19
    v_mul_f32 v20, s19, v20
    v_mul_f32 v21, s19, v21
    v_mul_f32 v22, s19, v22
    v_mul_f32 v23, s19, v23
    v_mul_f32 v24, s19, v24
    v_mul_f32 v25, s19, v25
    v_mul_f32 v26, s19, v26
    v_mul_f32 v27, s19, v27
    v_cvt_pk_bf16_f32 v16, v20, v21
    v_cvt_pk_bf16_f32 v17, v22, v23
    v_cvt_pk_bf16_f32 v18, v24, v25
    v_cvt_pk_bf16_f32 v19, v26, v27
    ds_write_b128 v82, v[16:19]
    ds_read_b64 v[28:29], v83
    ds_read_u16 v85, v84
    v_lshlrev_b32 v20, 16, v16
    v_and_b32 v21, s34, v16
    v_lshlrev_b32 v22, 16, v17
    v_and_b32 v23, s34, v17
    v_lshlrev_b32 v24, 16, v18
    v_and_b32 v25, s34, v18
    v_lshlrev_b32 v26, 16, v19
    v_and_b32 v27, s34, v19
    s_waitcnt lgkmcnt(0)
    v_perm_b32 v48, v28, v28, v64
    v_perm_b32 v49, v28, v28, v66
    v_perm_b32 v50, v28, v28, v68
    v_perm_b32 v51, v28, v28, v70
    v_perm_b32 v52, v28, v28, v65
    v_perm_b32 v53, v28, v28, v67
    v_perm_b32 v54, v28, v28, v69
    v_perm_b32 v55, v28, v28, v71
    v_perm_b32 v56, v29, v29, v64
    v_perm_b32 v57, v29, v29, v66
    v_perm_b32 v58, v29, v29, v68
    v_perm_b32 v59, v29, v29, v70
    v_perm_b32 v60, v29, v29, v65
    v_perm_b32 v61, v29, v29, v67
    v_perm_b32 v62, v29, v29, v69
    v_perm_b32 v63, v29, v29, v71
    s_add_u32 s58, s56, 1
    s_and_b32 s57, s58, s59
    s_and_b32 s72, s57, 0x7f
    s_or_b32 s72, s72, s73
    v_mov_b32 v15, s57
    v_mov_b32 v11, s72
    s_waitcnt vmcnt(4)
    v_mfma_f32_16x16x32_bf16 v[72:75], v[48:51], v[32:35], 0
    s_waitcnt vmcnt(3)
    v_mfma_f32_16x16x32_bf16 v[72:75], v[52:55], v[36:39], v[72:75]
    s_waitcnt vmcnt(2)
    v_mfma_f32_16x16x32_bf16 v[72:75], v[56:59], v[40:43], v[72:75]
    s_waitcnt vmcnt(1)
    v_mfma_f32_16x16x32_bf16 v[72:75], v[60:63], v[44:47], v[72:75]
    s_mov_b64 exec, s[76:77]
    s_nop 6
    ds_write_b128 v12, v[72:75]
    s_mov_b64 exec, 1
    ds_add_rtn_u32 v86, v80, v81
    s_mov_b64 exec, -1
    ds_read_b128 v[72:75], v13
    ds_read_b128 v[76:79], v13 offset:64
    s_waitcnt lgkmcnt(0)
    v_readfirstlane_b32 s61, v86
    s_cmp_lg_u32 s61, 3
    s_cbranch_scc1 L_pubdone
    v_add_f32 v72, v72, v76
    v_add_f32 v73, v73, v77
    v_add_f32 v74, v74, v78
    v_add_f32 v75, v75, v79
    v_add_f32_dpp v72, v72, v72 quad_perm:[1,0,3,2] row_mask:0xf bank_mask:0xf
    v_add_f32_dpp v73, v73, v73 quad_perm:[1,0,3,2] row_mask:0xf bank_mask:0xf
L_padM1:
    s_cbranch_execz L_retM
    v_add_f32_dpp v74, v74, v74 quad_perm:[1,0,3,2] row_mask:0xf bank_mask:0xf
    v_add_f32_dpp v75, v75, v75 quad_perm:[1,0,3,2] row_mask:0xf bank_mask:0xf
    v_add_f32_dpp v72, v72, v72 quad_perm:[2,3,0,1] row_mask:0xf bank_mask:0xf
    v_add_f32_dpp v73, v73, v73 quad_perm:[2,3,0,1] row_mask:0xf bank_mask:0xf
    v_add_f32_dpp v74, v74, v74 quad_perm:[2,3,0,1] row_mask:0xf bank_mask:0xf
    v_add_f32_dpp v75, v75, v75 quad_perm:[2,3,0,1] row_mask:0xf bank_mask:0xf
    v_bfi_b32 v72, s59, v11, v72
    v_bfi_b32 v73, s59, v15, v73
    v_bfi_b32 v74, s59, v15, v74
    v_bfi_b32 v75, s59, v15, v75
    s_mov_b32 exec_lo, 0x11111111
    s_mov_b32 exec_hi, 0x11111111
    buffer_store_dwordx4 v[72:75], v14, s[52:55], s74 offen
    ds_write_b32 v80, v81 offset:12
    buffer_store_dwordx4 v[72:75], v14, s[52:55], s75 offen sc1
    s_mov_b64 exec, -1
    s_waitcnt vmcnt(2)
    s_branch L_pubdone2
L_pubdone:
    s_waitcnt vmcnt(0)
L_pubdone2:
    v_lshlrev_b32 v92, 16, v91
    v_and_b32 v93, s34, v91
    v_readlane_b32 s78, v92, 24
    v_readlane_b32 s79, v93, 24
    v_readlane_b32 s73, v92, 25
    s_nop 1
    v_mov_b32 v72, s73
    v_mov_b32 v73, s73
    v_mov_b32 v74, s78
    v_mov_b32 v75, s79
    ds_write_b128 v80, v[72:75] offset:64
    v_add_f32 v8, v20, v21
    v_add_f32 v9, v22, v23
    v_add_f32 v8, v8, v24
    v_add_f32 v9, v9, v25
    v_add_f32 v8, v8, v26
    v_add_f32 v9, v9, v27
    v_add_f32 v8, v8, v9
    s_nop 1
    v_add_f32_dpp v8, v8, v8 quad_perm:[1,0,3,2] row_mask:0xf bank_mask:0xf
    s_nop 1
    v_add_f32_dpp v8, v8, v8 quad_perm:[2,3,0,1] row_mask:0xf bank_mask:0xf
    s_nop 1
    v_add_f32_dpp v8, v8, v8 row_half_mirror row_mask:0xf bank_mask:0xf
    s_nop 1
    v_add_f32_dpp v8, v8, v8 row_mirror row_mask:0xf bank_mask:0xf
    s_nop 1
    v_add_f32_dpp v8, v8, v8 row_bcast:15 row_mask:0xa bank_mask:0xf
    s_nop 1
    v_add_f32_dpp v8, v8, v8 row_bcast:31 row_mask:0xc bank_mask:0xf
    v_mul_f32 v8, s35, v8
    s_nop 0
    v_readlane_b32 s61, v8, 63
    v_cvt_pk_bf16_f32 v8, v8, v8
    v_lshlrev_b32 v8, 16, v8
    s_nop 0
    v_readlane_b32 s30, v8, 63
    v_subrev_f32 v9, s61, v20
    v_subrev_f32 v10, s61, v21
    v_mul_f32 v8, v9, v9
    v_mul_f32 v11, v10, v10
    v_subrev_f32 v9, s61, v22
    v_subrev_f32 v10, s61, v23
    v_fmac_f32 v8, v9, v9
    v_fmac_f32 v11, v10, v10
    v_subrev_f32 v9, s61, v24
    v_subrev_f32 v10, s61, v25
    v_fmac_f32 v8, v9, v9
    v_fmac_f32 v11, v10, v10
    v_subrev_f32 v9, s61, v26
    v_subrev_f32 v10, s61, v27
    v_fmac_f32 v8, v9, v9
    v_fmac_f32 v11, v10, v10
    v_add_f32 v8, v8, v11
    s_nop 1
    v_add_f32_dpp v8, v8, v8 quad_perm:[1,0,3,2] row_mask:0xf bank_mask:0xf
    s_nop 1
    v_add_f32_dpp v8, v8, v8 quad_perm:[2,3,0,1] row_mask:0xf bank_mask:0xf
    s_nop 1
    v_add_f32_dpp v8, v8, v8 row_half_mirror row_mask:0xf bank_mask:0xf
    s_nop 1
    v_add_f32_dpp v8, v8, v8 row_mirror row_mask:0xf bank_mask:0xf
    s_nop 1
    v_add_f32_dpp v8, v8, v8 row_bcast:15 row_mask:0xa bank_mask:0xf
    s_nop 1
    v_add_f32_dpp v8, v8, v8 row_bcast:31 row_mask:0xc bank_mask:0xf
    v_mul_f32 v8, s35, v8
    v_cvt_pk_bf16_f32 v8, v8, v8
    v_lshlrev_b32 v8, 16, v8
    v_add_f32 v8, 0x3727c5ac, v8
    v_cvt_pk_bf16_f32 v8, v8, v8
    v_lshlrev_b32 v8, 16, v8
    v_sqrt_f32 v8, v8
    s_nop 0
    v_cvt_pk_bf16_f32 v8, v8, v8
    v_lshlrev_b32 v8, 16, v8
    v_rcp_f32 v8, v8
    s_nop 0
    v_readlane_b32 s31, v8, 63
    v_lshlrev_b32 v8, 16, v85
    v_subrev_f32 v8, s30, v8
    v_cvt_pk_bf16_f32 v8, v8, v8
    v_lshlrev_b32 v8, 16, v8
    v_mul_f32 v8, s31, v8
    v_cvt_pk_bf16_f32 v8, v8, v8
    v_lshlrev_b32 v8, 16, v8
    v_mov_b32 v56, 0xbdd2d3e8
    v_mov_b32 v58, 0xc0135761
    v_mov_b32 v60, 1.0
    v_and_b32 v2, 15, v0
    v_lshrrev_b32 v1, 4, v0
    v_xor_b32 v7, v2, v1
    s_lshl_b32 s61, s64, 13
    v_lshlrev_b32 v24, 8, v2
    v_lshl_add_u32 v24, v7, 4, v24
    v_add_u32 v24, s61, v24
    v_xor_b32 v25, 64, v24
    v_xor_b32 v26, 128, v24
    v_xor_b32 v27, 192, v24
    v_and_b32 v9, 3, v0
    v_lshlrev_b32 v12, 8, v9
    v_lshl_add_u32 v28, v1, 4, v12
    v_add_u32 v28, 65536, v28
    v_lshlrev_b32 v12, 9, v9
    v_lshlrev_b32 v30, 4, v9
    v_add_u32 v30, 66560, v30
    s_lshl_b32 s61, s64, 2
    v_add_u32 v29, s61, v30
    v_lshlrev_b32 v31, 6, v1
    v_lshl_add_u32 v31, v9, 4, v31
    s_lshl_b32 s61, s64, 8
    s_add_u32 s61, s61, 67584
    v_add_u32 v31, s61, v31
    s_lshl_b32 s75, s4, 11
    s_lshl_b32 s61, s5, 4
    s_add_u32 s75, s75, s61
    s_add_u32 s75, s75, 196608
    s_lshl_b32 s61, s64, 2
    s_add_u32 s61, s61, 71936
    v_mov_b32 v23, s61
    v_readlane_b32 s60, v92, 0
    v_readlane_b32 s61, v93, 0
    v_readlane_b32 s62, v92, 8
    v_readlane_b32 s63, v93, 8
    v_readlane_b32 s76, v92, 16
    v_readlane_b32 s77, v93, 16
    v_readlane_b32 s8, v92, 1
    v_readlane_b32 s9, v93, 1
    v_readlane_b32 s10, v92, 9
    v_readlane_b32 s11, v93, 9
    v_readlane_b32 s12, v92, 17
    v_readlane_b32 s13, v93, 17
    v_pk_mul_f32 v[62:63], v[8:9], s[60:61] op_sel_hi:[0,1]
    v_pk_mul_f32 v[66:67], v[8:9], s[8:9] op_sel_hi:[0,1]
    v_cvt_pk_bf16_f32 v64, v62, v63
    v_cvt_pk_bf16_f32 v68, v66, v67
    v_lshlrev_b32 v62, 16, v64
    v_and_b32 v63, s34, v64
    v_lshlrev_b32 v66, 16, v68
    v_and_b32 v67, s34, v68
    v_pk_add_f32 v[62:63], v[62:63], s[62:63]
    v_pk_add_f32 v[66:67], v[66:67], s[10:11]
    v_cvt_pk_bf16_f32 v64, v62, v63
    v_cvt_pk_bf16_f32 v68, v66, v67
    v_lshlrev_b32 v62, 16, v64
    v_and_b32 v63, s34, v64
    v_lshlrev_b32 v66, 16, v68
    v_and_b32 v67, s34, v68
    v_pk_mul_f32 v[64:65], v[62:63], v[62:63]
    v_pk_mul_f32 v[68:69], v[66:67], v[66:67]
    v_pk_fma_f32 v[64:65], v[64:65], v[56:57], v[58:59] op_sel_hi:[1,0,0]
    v_pk_fma_f32 v[68:69], v[68:69], v[56:57], v[58:59] op_sel_hi:[1,0,0]
    v_pk_mul_f32 v[64:65], v[64:65], v[62:63]
    v_pk_mul_f32 v[68:69], v[68:69], v[66:67]
    v_exp_f32 v64, v64
    v_exp_f32 v65, v65
    v_exp_f32 v68, v68
L_padM2:
    s_cbranch_execz L_retM
    v_exp_f32 v69, v69
    v_pk_add_f32 v[64:65], v[64:65], v[60:61] op_sel_hi:[1,0]
    v_pk_add_f32 v[68:69], v[68:69], v[60:61] op_sel_hi:[1,0]
    v_rcp_f32 v64, v64
    v_rcp_f32 v65, v65
    v_rcp_f32 v68, v68
    v_rcp_f32 v69, v69
    v_pk_mul_f32 v[62:63], v[62:63], v[64:65]
    v_pk_mul_f32 v[66:67], v[66:67], v[68:69]
    v_cvt_pk_bf16_f32 v64, v62, v63
    v_cvt_pk_bf16_f32 v68, v66, v67
    v_lshlrev_b32 v62, 16, v64
    v_and_b32 v63, s34, v64
    v_lshlrev_b32 v66, 16, v68
    v_and_b32 v67, s34, v68
    v_pk_mul_f32 v[14:15], v[62:63], s[76:77]
    v_pk_fma_f32 v[14:15], v[66:67], s[12:13], v[14:15]
    v_readlane_b32 s60, v92, 2
    v_readlane_b32 s61, v93, 2
    v_readlane_b32 s62, v92, 10
    v_readlane_b32 s63, v93, 10
    v_readlane_b32 s76, v92, 18
    v_readlane_b32 s77, v93, 18
    v_readlane_b32 s8, v92, 3
    v_readlane_b32 s9, v93, 3
    v_readlane_b32 s10, v92, 11
    v_readlane_b32 s11, v93, 11
    v_readlane_b32 s12, v92, 19
    v_readlane_b32 s13, v93, 19
    v_pk_mul_f32 v[62:63], v[8:9], s[60:61] op_sel_hi:[0,1]
    v_pk_mul_f32 v[66:67], v[8:9], s[8:9] op_sel_hi:[0,1]
    v_cvt_pk_bf16_f32 v64, v62, v63
    v_cvt_pk_bf16_f32 v68, v66, v67
    v_lshlrev_b32 v62, 16, v64
    v_and_b32 v63, s34, v64
    v_lshlrev_b32 v66, 16, v68
    v_and_b32 v67, s34, v68
    v_pk_add_f32 v[62:63], v[62:63], s[62:63]
    v_pk_add_f32 v[66:67], v[66:67], s[10:11]
    v_cvt_pk_bf16_f32 v64, v62, v63
    v_cvt_pk_bf16_f32 v68, v66, v67
    v_lshlrev_b32 v62, 16, v64
    v_and_b32 v63, s34, v64
    v_lshlrev_b32 v66, 16, v68
    v_and_b32 v67, s34, v68
    v_pk_mul_f32 v[64:65], v[62:63], v[62:63]
    v_pk_mul_f32 v[68:69], v[66:67], v[66:67]
    v_pk_fma_f32 v[64:65], v[64:65], v[56:57], v[58:59] op_sel_hi:[1,0,0]
    v_pk_fma_f32 v[68:69], v[68:69], v[56:57], v[58:59] op_sel_hi:[1,0,0]
    v_pk_mul_f32 v[64:65], v[64:65], v[62:63]
    v_pk_mul_f32 v[68:69], v[68:69], v[66:67]
    v_exp_f32 v64, v64
    v_exp_f32 v65, v65
    v_exp_f32 v68, v68
    v_exp_f32 v69, v69
    v_pk_add_f32 v[64:65], v[64:65], v[60:61] op_sel_hi:[1,0]
    v_pk_add_f32 v[68:69], v[68:69], v[60:61] op_sel_hi:[1,0]
    v_rcp_f32 v64, v64
    v_rcp_f32 v65, v65
    v_rcp_f32 v68, v68
    v_rcp_f32 v69, v69
    v_pk_mul_f32 v[62:63], v[62:63], v[64:65]
    v_pk_mul_f32 v[66:67], v[66:67], v[68:69]
    v_cvt_pk_bf16_f32 v64, v62, v63
    v_cvt_pk_bf16_f32 v68, v66, v67
    v_lshlrev_b32 v62, 16, v64
    v_and_b32 v63, s34, v64
    v_lshlrev_b32 v66, 16, v68
    v_and_b32 v67, s34, v68
    v_pk_fma_f32 v[14:15], v[62:63], s[76:77], v[14:15]
    v_pk_fma_f32 v[14:15], v[66:67], s[12:13], v[14:15]
    buffer_load_dwordx4 v[32:35], v4, s[52:55], s70 offen sc1
    buffer_load_dwordx4 v[36:39], v97, s[52:55], s70 offen sc1
    v_readlane_b32 s60, v92, 4
    v_readlane_b32 s61, v93, 4
    v_readlane_b32 s62, v92, 12
    v_readlane_b32 s63, v93, 12
    v_readlane_b32 s76, v92, 20
    v_readlane_b32 s77, v93, 20
    v_readlane_b32 s8, v92, 5
    v_readlane_b32 s9, v93, 5
    v_readlane_b32 s10, v92, 13
    v_readlane_b32 s11, v93, 13
    v_readlane_b32 s12, v92, 21
    v_readlane_b32 s13, v93, 21
    v_pk_mul_f32 v[62:63], v[8:9], s[60:61] op_sel_hi:[0,1]
    v_pk_mul_f32 v[66:67], v[8:9], s[8:9] op_sel_hi:[0,1]
    v_cvt_pk_bf16_f32 v64, v62, v63
    v_cvt_pk_bf16_f32 v68, v66, v67
    v_lshlrev_b32 v62, 16, v64
    v_and_b32 v63, s34, v64
    v_lshlrev_b32 v66, 16, v68
    v_and_b32 v67, s34, v68
    v_pk_add_f32 v[62:63], v[62:63], s[62:63]
    v_pk_add_f32 v[66:67], v[66:67], s[10:11]
    v_cvt_pk_bf16_f32 v64, v62, v63
    v_cvt_pk_bf16_f32 v68, v66, v67
    v_lshlrev_b32 v62, 16, v64
    v_and_b32 v63, s34, v64
    v_lshlrev_b32 v66, 16, v68
    v_and_b32 v67, s34, v68
    v_pk_mul_f32 v[64:65], v[62:63], v[62:63]
    v_pk_mul_f32 v[68:69], v[66:67], v[66:67]
    v_pk_fma_f32 v[64:65], v[64:65], v[56:57], v[58:59] op_sel_hi:[1,0,0]
    v_pk_fma_f32 v[68:69], v[68:69], v[56:57], v[58:59] op_sel_hi:[1,0,0]
    v_pk_mul_f32 v[64:65], v[64:65], v[62:63]
    v_pk_mul_f32 v[68:69], v[68:69], v[66:67]
    v_exp_f32 v64, v64
    v_exp_f32 v65, v65
    v_exp_f32 v68, v68
    v_exp_f32 v69, v69
    v_pk_add_f32 v[64:65], v[64:65], v[60:61] op_sel_hi:[1,0]
    v_pk_add_f32 v[68:69], v[68:69], v[60:61] op_sel_hi:[1,0]
    v_rcp_f32 v64, v64
    v_rcp_f32 v65, v65
    v_rcp_f32 v68, v68
    v_rcp_f32 v69, v69
    v_pk_mul_f32 v[62:63], v[62:63], v[64:65]
    v_pk_mul_f32 v[66:67], v[66:67], v[68:69]
    v_cvt_pk_bf16_f32 v64, v62, v63
    v_cvt_pk_bf16_f32 v68, v66, v67
    v_lshlrev_b32 v62, 16, v64
    v_and_b32 v63, s34, v64
    v_lshlrev_b32 v66, 16, v68
    v_and_b32 v67, s34, v68
    v_pk_fma_f32 v[14:15], v[62:63], s[76:77], v[14:15]
    v_pk_fma_f32 v[14:15], v[66:67], s[12:13], v[14:15]
    v_readlane_b32 s60, v92, 6
    v_readlane_b32 s61, v93, 6
    v_readlane_b32 s62, v92, 14
    v_readlane_b32 s63, v93, 14
    v_readlane_b32 s76, v92, 22
    v_readlane_b32 s77, v93, 22
    v_pk_mul_f32 v[62:63], v[8:9], s[60:61] op_sel_hi:[0,1]
    s_nop 0
    v_cvt_pk_bf16_f32 v64, v62, v63
    v_lshlrev_b32 v62, 16, v64
    v_and_b32 v63, s34, v64
    v_pk_add_f32 v[62:63], v[62:63], s[62:63]
    v_cvt_pk_bf16_f32 v64, v62, v63
    v_lshlrev_b32 v62, 16, v64
    v_and_b32 v63, s34, v64
    v_pk_mul_f32 v[64:65], v[62:63], v[62:63]
    v_pk_fma_f32 v[64:65], v[64:65], v[56:57], v[58:59] op_sel_hi:[1,0,0]
    s_nop 0
    v_pk_mul_f32 v[64:65], v[64:65], v[62:63]
    v_exp_f32 v64, v64
    v_exp_f32 v65, v65
    s_nop 0
    v_pk_add_f32 v[64:65], v[64:65], v[60:61] op_sel_hi:[1,0]
    s_nop 0
    v_rcp_f32 v64, v64
    v_rcp_f32 v65, v65
    s_nop 0
    v_pk_mul_f32 v[62:63], v[62:63], v[64:65]
    v_cvt_pk_bf16_f32 v64, v62, v63
    v_lshlrev_b32 v62, 16, v64
    v_and_b32 v63, s34, v64
    v_pk_fma_f32 v[14:15], v[62:63], s[76:77], v[14:15]
    v_add_f32 v13, v14, v15
L_padM3:
    s_cbranch_execz L_retM
    s_lshl_b32 s61, s64, 8
    s_add_u32 s62, s61, 74096
    v_lshl_add_u32 v8, v0, 2, s62
    ds_write_b32 v8, v13
    s_mov_b32 s18, 0x3db504f3
    s_mov_b32 s19, s18
    s_mov_b32 s20, 0x3fb8aa3b
    s_mov_b32 s76, 0x000f000f
    s_mov_b32 s77, s76
    s_mov_b32 s64, 0
    s_mov_b32 s60, 0
    v_mov_b32 v2, v80
    v_mov_b32 v5, 1
    v_mov_b32 v7, v87
    v_mov_b32 v6, v12
    s_mov_b32 s61, 0
L_lspin0:
    ds_read_b32 v9, v23 offset:16
    s_add_u32 s61, s61, 1
    s_cmp_ge_u32 s61, 7
    s_cbranch_scc1 L_lspin0_x
    s_waitcnt lgkmcnt(0)
    v_cmp_ne_u32 vcc, 1, v9
    s_cbranch_vccnz L_lspin0
L_lspin0_x:
    buffer_load_dwordx4 v[40:43], v4, s[52:55], s70 offen sc1
    buffer_load_dwordx4 v[44:47], v97, s[52:55], s70 offen sc1
L_kspin:
    ds_read_b32 v9, v23 offset:16
    s_add_u32 s60, s60, 1
    s_cmp_gt_u32 s60, 800000
    s_cbranch_scc1 L_kspin_x
    s_waitcnt lgkmcnt(0)
    v_cmp_ne_u32 vcc, 1, v9
    s_cbranch_vccnz L_kspin
L_kspin_x:
    ds_read_b128 v[56:59], v24 offset:0
    ds_read_b128 v[60:63], v25 offset:0
    ds_read_b128 v[64:67], v26 offset:0
    ds_read_b128 v[68:71], v27 offset:0
    ds_read_b128 v[72:75], v24 offset:4096
    ds_read_b128 v[76:79], v25 offset:4096
    ds_read_b128 v[80:83], v26 offset:4096
    ds_read_b128 v[84:87], v27 offset:4096
    s_mov_b32 s71, s70
L_qring:
    s_waitcnt vmcnt(2)
    v_xor_b32 v88, s72, v32
    v_xor_b32 v92, s72, v36
    v_xor_b32 v89, s57, v33
    v_xor_b32 v90, s57, v34
    v_xor_b32 v91, s57, v35
    v_xor_b32 v93, s57, v37
    v_xor_b32 v94, s57, v38
    v_xor_b32 v95, s57, v39
    v_or_b32 v11, v88, v92
    v_or3_b32 v10, v89, v90, v91
    v_or3_b32 v13, v93, v94, v95
    v_and_b32 v9, 0x7f, v11
    v_or_b32 v10, v10, v13
    v_and_or_b32 v9, v10, s59, v9
    v_cmp_ne_u32 vcc, 0, v9
    s_cbranch_vccz L_qgo
    buffer_load_dwordx4 v[32:35], v4, s[52:55], s70 offen sc1
    buffer_load_dwordx4 v[36:39], v97, s[52:55], s70 offen sc1
    s_add_u32 s64, s64, 1
    s_waitcnt vmcnt(2)
    v_xor_b32 v88, s72, v40
    v_xor_b32 v92, s72, v44
    v_xor_b32 v89, s57, v41
    v_xor_b32 v90, s57, v42
    v_xor_b32 v91, s57, v43
    v_xor_b32 v93, s57, v45
    v_xor_b32 v94, s57, v46
    v_xor_b32 v95, s57, v47
    v_or_b32 v11, v88, v92
    v_or3_b32 v10, v89, v90, v91
    v_or3_b32 v13, v93, v94, v95
    v_and_b32 v9, 0x7f, v11
    v_or_b32 v10, v10, v13
    v_and_or_b32 v9, v10, s59, v9
    v_cmp_ne_u32 vcc, 0, v9
    s_cbranch_vccz L_qgo
    buffer_load_dwordx4 v[40:43], v4, s[52:55], s71 offen sc1
    buffer_load_dwordx4 v[44:47], v97, s[52:55], s71 offen sc1
    s_add_u32 s64, s64, 1
    s_add_u32 s71, s70, 65536
    s_cmp_le_u32 s64, 100000
    s_cbranch_scc1 L_qring
L_qgo:
    v_and_b32 v9, s59, v11
    v_bfi_b32 v88, s59, 0, v88
    v_bfi_b32 v92, s59, 0, v92
    v_cmp_ne_u32 vcc, 0, v9
    v_add_f32 v88, v88, v92
    v_add_f32 v89, v89, v93
    v_add_f32 v90, v90, v94
    v_add_f32 v91, v91, v95
    s_cmp_eq_u64 vcc, 0
    s_cselect_b32 s61, 1, 0
    v_permlane32_swap_b32 v88, v90
    v_permlane32_swap_b32 v89, v91
    v_mov_b32 v10, s61
    v_add_f32 v88, v88, v90
    v_add_f32 v89, v89, v91
    v_cvt_pk_bf16_f32 v88, v88, v89
    ds_write_b32 v7, v88
    ds_write_b32 v23, v10
    s_mov_b64 exec, 1
    ds_add_u32 v2, v5 offset:4
    s_mov_b64 exec, -1
L_qspin:
    ds_read_b32 v24, v2 offset:4
    ds_read_b128 v[8:11], v28 offset:0
    ds_read_b128 v[12:15], v28 offset:64
    ds_read_b128 v[16:19], v28 offset:128
    ds_read_b128 v[20:23], v28 offset:192
    s_add_u32 s60, s60, 1
    s_cmp_gt_u32 s60, 800000
    s_cbranch_scc1 L_qspin_x
    s_waitcnt lgkmcnt(4)
    v_cmp_ne_u32 vcc, 4, v24
    s_cbranch_vccnz L_qspin
L_qspin_x:
    s_waitcnt lgkmcnt(3)
    v_mfma_f32_16x16x32_bf16 v[88:91], v[56:59], v[8:11], 0
    v_mfma_f32_16x16x32_bf16 v[92:95], v[72:75], v[8:11], 0
    s_waitcnt lgkmcnt(2)
    v_mfma_f32_16x16x32_bf16 v[88:91], v[60:63], v[12:15], v[88:91]
    v_mfma_f32_16x16x32_bf16 v[92:95], v[76:79], v[12:15], v[92:95]
    s_waitcnt lgkmcnt(1)
    v_mfma_f32_16x16x32_bf16 v[88:91], v[64:67], v[16:19], v[88:91]
    v_mfma_f32_16x16x32_bf16 v[92:95], v[80:83], v[16:19], v[92:95]
    s_waitcnt lgkmcnt(0)
    v_mfma_f32_16x16x32_bf16 v[88:91], v[68:71], v[20:23], v[88:91]
    v_mfma_f32_16x16x32_bf16 v[92:95], v[84:87], v[20:23], v[92:95]
    s_nop 6
    v_cvt_pk_bf16_f32 v96, v88, v89
    v_cvt_pk_bf16_f32 v97, v90, v91
    v_cvt_pk_bf16_f32 v98, v92, v93
    v_cvt_pk_bf16_f32 v99, v94, v95
    v_lshlrev_b32 v88, 16, v96
    v_and_b32 v89, s34, v96
    v_lshlrev_b32 v90, 16, v97
    v_and_b32 v91, s34, v97
    v_lshlrev_b32 v92, 16, v98
    v_and_b32 v93, s34, v98
    v_lshlrev_b32 v94, 16, v99
    v_and_b32 v95, s34, v99
    v_pk_mul_f32 v[88:89], v[88:89], s[18:19]
    v_pk_mul_f32 v[90:91], v[90:91], s[18:19]
    v_pk_mul_f32 v[92:93], v[92:93], s[18:19]
    v_pk_mul_f32 v[94:95], v[94:95], s[18:19]
    v_cvt_pk_bf16_f32 v96, v88, v89
    v_cvt_pk_bf16_f32 v97, v90, v91
    v_cvt_pk_bf16_f32 v98, v92, v93
    v_cvt_pk_bf16_f32 v99, v94, v95
    v_lshlrev_b32 v88, 16, v96
    v_and_b32 v89, s34, v96
    v_lshlrev_b32 v90, 16, v97
    v_and_b32 v91, s34, v97
    v_lshlrev_b32 v92, 16, v98
    v_and_b32 v93, s34, v98
    v_lshlrev_b32 v94, 16, v99
    v_and_b32 v95, s34, v99
    v_max3_f32 v9, v88, v89, v90
    v_max3_f32 v10, v91, v92, v93
    v_max3_f32 v9, v9, v94, v95
    v_max_f32 v9, v9, v10
    v_mov_b32 v10, v9
    s_nop 1
    v_permlane16_swap_b32 v9, v10
    v_max_f32 v9, v9, v10
    v_mov_b32 v10, v9
    s_nop 1
    v_permlane32_swap_b32 v9, v10
    v_max_f32 v9, v9, v10
    ds_write_b32 v29, v9
    s_mov_b64 exec, 1
    ds_add_u32 v2, v5 offset:8
    s_mov_b64 exec, -1
L_mspin:
    ds_read_b32 v11, v2 offset:8
    ds_read_b128 v[12:15], v30
    s_add_u32 s60, s60, 1
    s_cmp_gt_u32 s60, 800000
    s_cbranch_scc1 L_mspin_x
    s_waitcnt lgkmcnt(0)
    v_cmp_ne_u32 vcc, 4, v11
    v_max3_f32 v8, v12, v13, v14
L_padN0:
    s_cbranch_execz L_retN
    v_max_f32 v8, v8, v15
    s_cbranch_vccnz L_mspin
L_mspin_x:
    v_mul_f32 v8, s20, v8
    v_fma_f32 v88, v88, s20, -v8
    v_fma_f32 v89, v89, s20, -v8
    v_fma_f32 v90, v90, s20, -v8
    v_fma_f32 v91, v91, s20, -v8
    v_fma_f32 v92, v92, s20, -v8
    v_fma_f32 v93, v93, s20, -v8
    v_fma_f32 v94, v94, s20, -v8
    v_fma_f32 v95, v95, s20, -v8
    v_exp_f32 v88, v88
    v_exp_f32 v89, v89
    v_exp_f32 v90, v90
    v_exp_f32 v91, v91
    v_exp_f32 v92, v92
    v_exp_f32 v93, v93
    v_exp_f32 v94, v94
    v_exp_f32 v95, v95
    v_cvt_pk_bf16_f32 v96, v88, v89
    v_cvt_pk_bf16_f32 v97, v90, v91
    v_cvt_pk_bf16_f32 v98, v92, v93
    v_cvt_pk_bf16_f32 v99, v94, v95
    s_mov_b64 exec, s[76:77]
    ds_write_b128 v31, v[96:99]
    s_mov_b64 exec, 1
    ds_add_u32 v2, v5 offset:20
    s_mov_b64 exec, -1
    v_add_f32 v9, v88, v89
    v_add_f32 v13, v90, v91
    v_add_f32 v9, v9, v92
    v_add_f32 v13, v13, v93
    v_add_f32 v9, v9, v94
    v_add_f32 v13, v13, v95
    v_add_f32 v9, v9, v13
    v_mov_b32 v13, v9
    s_nop 1
    v_permlane16_swap_b32 v9, v13
    v_add_f32 v9, v9, v13
    v_mov_b32 v13, v9
    s_nop 1
    v_permlane32_swap_b32 v9, v13
    v_add_f32 v9, v9, v13
    ds_write_b32 v29, v9 offset:64
    s_mov_b64 exec, 1
    ds_add_rtn_u32 v11, v2, v5 offset:28
    s_mov_b64 exec, -1
    ds_read_b128 v[12:15], v30 offset:64
    v_add_u32 v7, -32, v2
    ds_read_b128 v[24:27], v7
    s_waitcnt lgkmcnt(0)
    v_readfirstlane_b32 s61, v11
    s_cmp_eq_u32 s61, 0
    s_cbranch_scc1 L_ypub
    s_cmp_lg_u32 s61, 3
    s_cbranch_scc1 L_auxpost
    v_mov_b32 v9, v8
    v_mov_b32 v8, s58
    v_mov_b32 v11, s58
    s_waitcnt lgkmcnt(0)
    v_add_f32 v12, v12, v13
    v_add_f32 v14, v14, v15
    v_add_f32 v10, v12, v14
    v_and_b32 v24, v24, v25
    v_and_b32 v26, v26, v27
    v_and_b32 v24, v24, v26
    s_nop 0
    v_readfirstlane_b32 s30, v24
    s_mov_b64 exec, 15
    s_cmp_eq_u32 s30, 1
    s_cbranch_scc0 L_st_rem
    buffer_store_dwordx4 v[8:11], v6, s[52:55], s75 offen
L_st_done:
    s_mov_b64 exec, -1
    s_branch L_auxpost
L_ypub:
    v_lshrrev_b32 v9, 2, v0
    v_lshlrev_b32 v9, 4, v9
    v_and_b32 v8, 3, v0
    v_lshl_add_u32 v8, v8, 8, v9
    v_add_u32 v8, 74096, v8
    ds_read_b128 v[16:19], v8
    s_lshl_b32 s61, s4, 13
    s_lshl_b32 s62, s5, 8
    s_add_u32 s61, s61, s62
    s_add_u32 s61, s61, 532480
    v_mov_b32 v15, s57
    s_waitcnt lgkmcnt(0)
    v_add_f32_dpp v16, v16, v16 quad_perm:[1,0,3,2] row_mask:0xf bank_mask:0xf
    v_add_f32_dpp v17, v17, v17 quad_perm:[1,0,3,2] row_mask:0xf bank_mask:0xf
    v_add_f32_dpp v18, v18, v18 quad_perm:[1,0,3,2] row_mask:0xf bank_mask:0xf
    v_add_f32_dpp v19, v19, v19 quad_perm:[1,0,3,2] row_mask:0xf bank_mask:0xf
    v_add_f32_dpp v16, v16, v16 quad_perm:[2,3,0,1] row_mask:0xf bank_mask:0xf
    v_add_f32_dpp v17, v17, v17 quad_perm:[2,3,0,1] row_mask:0xf bank_mask:0xf
    v_add_f32_dpp v18, v18, v18 quad_perm:[2,3,0,1] row_mask:0xf bank_mask:0xf
    v_add_f32_dpp v19, v19, v19 quad_perm:[2,3,0,1] row_mask:0xf bank_mask:0xf
    v_bfi_b32 v16, s59, v15, v16
    v_bfi_b32 v17, s59, v15, v17
    v_bfi_b32 v18, s59, v15, v18
    v_bfi_b32 v19, s59, v15, v19
    s_mov_b32 exec_lo, 0x11111111
    s_mov_b32 exec_hi, 0x11111111
    buffer_store_dwordx4 v[16:19], v9, s[52:55], s61 offen sc1
    s_mov_b64 exec, -1
L_auxpost:
    s_mov_b32 s62, 0
    s_mov_b32 s63, 0
    s_branch L_fin
L_retN:
    s_mov_b64 exec, -1
    s_cmp_eq_u32 s0, 0
    s_cbranch_scc0 L_end
    s_mov_b64 s[40:41], s[12:13]
    s_mov_b32 s64, 0
    v_and_b32 v8, 3, v0
    v_lshlrev_b32 v9, 5, v1
    v_xor_b32 v20, v3, v9
    s_and_b32 s61, s3, 1
    s_lshl_b32 s61, s61, 7
    v_xor_b32 v20, s61, v20
    buffer_load_dwordx4 v16, s[36:39], s70 offen offset:0 nt lds
    buffer_load_dwordx4 v17, s[36:39], s70 offen offset:1024 nt lds
    buffer_load_dwordx4 v18, s[36:39], s70 offen offset:2048 nt lds
    buffer_load_dwordx4 v19, s[36:39], s70 offen offset:3072 nt lds
    v_lshrrev_b32 v25, 2, v0
    v_and_b32 v9, 7, v25
    s_lshl_b32 s61, s3, 1
    v_xor_b32 v9, s61, v9
    v_lshlrev_b32 v25, 8, v25
    v_lshl_add_u32 v25, v9, 5, v25
    v_lshl_add_u32 v25, v8, 3, v25
    v_add_u32 v25, 32768, v25
    v_xor_b32 v26, 32, v25
    v_bfe_u32 v10, v0, 2, 2
    v_lshlrev_b32 v31, 6, v1
    v_lshl_add_u32 v31, v8, 4, v31
    v_add_u32 v31, 67584, v31
    v_lshlrev_b32 v33, 14, v8
    v_lshl_add_u32 v33, v10, 11, v33
    v_lshl_add_u32 v33, v1, 8, v33
    v_mov_b32 v32, 71968
    s_mov_b32 s76, 0x00f000f0
    s_mov_b32 s77, s76
    v_lshrrev_b32 v28, 2, v0
    v_lshlrev_b32 v21, 8, v28
    v_lshl_add_u32 v21, v8, 4, v21
    v_and_b32 v9, 16, v0
    v_lshlrev_b32 v9, 1, v9
    v_xor_b32 v21, v21, v9
    v_lshlrev_b32 v28, 6, v28
    v_lshl_add_u32 v28, v8, 3, v28
    v_add_u32 v28, v9, v28
    s_lshl_b32 s61, s3, 11
    s_add_u32 s61, s61, 32768
    v_add_u32 v28, s61, v28
    v_xor_b32 v29, 32, v28
    s_lshl_b32 s74, s4, 16
    s_lshl_b32 s61, s3, 12
    s_add_u32 s74, s74, s61
    s_and_b32 s61, s5, 15
    s_lshl_b32 s61, s61, 4
    s_add_u32 s74, s74, s61
    s_lshr_b32 s61, s5, 4
    s_lshl_b32 s61, s61, 10
    s_add_u32 s74, s74, s61
    s_add_u32 s74, s74, 1048576
    s_mov_b32 s78, 0x00ff00ff
    s_mov_b32 s79, s78
    v_mov_b32 v35, 71936
    s_lshl_b32 s61, s3, 2
    v_add_u32 v34, s61, v35
    v_mov_b32 v27, 1
    s_mov_b32 s54, 0x10000000
    s_mov_b32 s47, s39
    s_mov_b32 s51, s39
    s_mov_b32 s55, s39
    s_movk_i32 s59, 0x3ff
    s_mov_b32 s34, 0xffff0000
    s_mov_b64 s[52:53], s[32:33]
    v_lshlrev_b32 v121, 12, v1
    v_lshl_add_u32 v121, v2, 4, v121
    s_lshl_b32 s62, s4, 3
    s_lshr_b32 s61, s5, 2
    s_add_u32 s62, s62, s61
    s_and_b32 s63, s5, 3
    s_lshl_b32 s1, s62, 16
    s_lshl_b32 s61, s3, 14
    s_add_u32 s1, s1, s61
    s_lshl_b32 s61, s63, 8
    s_add_u32 s1, s1, s61
    s_mov_b32 s46, 0x400000
    s_mov_b64 s[44:45], s[16:17]
    v_and_b32 v38, 1, v0
    v_cmp_eq_u32 vcc, 1, v38
    v_mov_b32 v126, 0x0c0c0100
L_padN1:
    s_cbranch_execz L_retN
    v_mov_b32 v127, 0x01000c0c
    v_cndmask_b32 v126, v126, v127, vcc
    v_mov_b32 v38, 0x0202
    v_mov_b32 v127, 0x02020000
    v_cndmask_b32 v127, v38, v127, vcc
    v_add_u32 v127, v126, v127
    v_bfe_u32 v38, v0, 1, 2
    v_mov_b32 v39, 0x0c0c0c0c
    v_cmp_eq_u32 vcc, 0, v38
    s_lshl_b32 s66, s62, 13
    s_lshl_b32 s61, s3, 11
    v_cndmask_b32 v112, v39, v126, vcc
    v_cndmask_b32 v113, v39, v127, vcc
    v_cmp_eq_u32 vcc, 1, v38
    s_add_u32 s66, s66, s61
    s_lshr_b32 s67, s62, 1
    v_cndmask_b32 v114, v39, v126, vcc
    v_cndmask_b32 v115, v39, v127, vcc
    v_cmp_eq_u32 vcc, 2, v38
    s_lshl_b32 s67, s67, 9
    s_add_u32 s67, s67, 196608
    v_cndmask_b32 v116, v39, v126, vcc
    v_cndmask_b32 v117, v39, v127, vcc
    v_cmp_eq_u32 vcc, 3, v38
    v_and_b32 v120, 31, v0
    v_lshlrev_b32 v120, 4, v120
    v_cndmask_b32 v118, v39, v126, vcc
    v_cndmask_b32 v119, v39, v127, vcc
    s_add_u32 s66, s66, 1048576
    s_mul_i32 s61, s3, 528
    v_add_u32 v122, s61, v3
    s_lshl_b32 s65, s63, 16
    s_lshr_b32 s61, s3, 1
    s_lshl_b32 s61, s61, 15
    s_add_u32 s65, s65, s61
    s_lshr_b32 s61, s62, 5
    s_lshl_b32 s61, s61, 14
    s_add_u32 s65, s65, s61
    s_and_b32 s61, s62, 31
    s_lshl_b32 s61, s61, 8
    s_add_u32 s65, s65, s61
    s_and_b32 s61, s3, 1
    s_lshl_b32 s61, s61, 7
    s_add_u32 s65, s65, s61
    s_add_u32 s65, s65, 262144
    v_mul_u32_u24 v126, 528, v8
    v_bfe_u32 v127, v0, 3, 2
    v_lshl_add_u32 v126, v127, 4, v126
    v_bfe_u32 v127, v0, 2, 1
    v_lshl_add_u32 v126, v127, 8, v126
    s_lshl_b32 s61, s3, 6
    v_add_u32 v123, s61, v126
    v_bfe_u32 v127, v0, 2, 3
    v_lshlrev_b32 v124, 4, v127
    s_movk_i32 s50, 1024
    s_mov_b64 s[48:49], s[28:29]
    v_lshrrev_b32 v126, 5, v0
    v_lshlrev_b32 v126, 14, v126
    v_lshl_add_u32 v125, v120, 4, v126
    s_lshl_b32 s69, s4, 7
    s_lshl_b32 s61, s5, 2
    s_add_u32 s69, s69, s61
    s_lshr_b32 s68, s5, 1
    s_lshl_b32 s68, s68, 4
    s_lshl_b32 s61, s4, 15
    s_add_u32 s68, s68, s61
    s_add_u32 s68, s68, 262144
    s_add_u32 s18, s65, 0x2000
    s_lshr_b32 s61, s63, 1
    s_xor_b32 s61, s61, 0
    s_lshl_b32 s61, s61, 13
    s_add_u32 s65, s65, s61
    v_lshlrev_b32 v126, 4, v120
    s_lshl_b32 s31, s4, 13
    s_lshr_b32 s61, s5, 1
    s_lshl_b32 s61, s61, 4
    s_add_u32 s31, s31, s61
    s_add_u32 s31, s31, 532480
    s_lshl_b32 s60, s62, 13
    s_and_b32 s61, s5, 3
    s_lshl_b32 s61, s61, 11
    s_add_u32 s60, s60, s61
    s_add_u32 s60, s60, 1048576
    s_lshl_b32 s61, s4, 11
    s_add_u32 s61, s61, 196608
    s_cmp_ge_u32 s3, 2
    s_cselect_b32 s60, s61, s60
    s_and_b32 s61, s3, 1
    s_lshl_b32 s61, s61, 10
    s_add_u32 s60, s60, s61
    buffer_load_dwordx4 v[60:63], v3, s[52:55], s60 offen sc1
    s_lshr_b32 s61, s4, 2
    s_xor_b32 s61, s61, 0
    s_lshl_b32 s61, s61, 13
    s_add_u32 s68, s68, s61
    s_mov_b32 s60, 0
    v_mov_b32 v36, 71968
L_gspin:
    ds_read_b32 v37, v36 offset:12
    s_add_u32 s60, s60, 1
    s_cmp_gt_u32 s60, 800000
    s_cbranch_scc1 L_gspin_x
    s_waitcnt lgkmcnt(0)
    v_cmp_ne_u32 vcc, 1, v37
    s_cbranch_vccnz L_gspin
L_gspin_x:
    s_add_u32 m0, s73, 4096
    s_nop 0
    buffer_load_dwordx4 v16, s[36:39], s71 offen offset:0 nt lds
    s_waitcnt vmcnt(4)
    buffer_load_dwordx4 v17, s[36:39], s71 offen offset:1024 nt lds
    s_waitcnt vmcnt(4)
    buffer_load_dwordx4 v18, s[36:39], s71 offen offset:2048 nt lds
    s_waitcnt vmcnt(4)
    buffer_load_dwordx4 v19, s[36:39], s71 offen offset:3072 nt lds
    s_add_u32 m0, s75, 32768
    s_waitcnt vmcnt(4)
    buffer_load_dwordx4 v20, s[40:43], s72 offen nt lds
    s_xor_b32 s72, s72, 0x00021000
    s_add_u32 m0, s75, 36864
    s_waitcnt vmcnt(4)
    buffer_load_dwordx4 v20, s[40:43], s72 offen nt lds
    s_xor_b32 s72, s72, 0x00063000
    s_add_u32 m0, s75, 40960
    s_waitcnt vmcnt(4)
    buffer_load_dwordx4 v20, s[40:43], s72 offen nt lds
    s_xor_b32 s72, s72, 0x00021000
    s_add_u32 m0, s75, 45056
    s_waitcnt vmcnt(4)
    buffer_load_dwordx4 v20, s[40:43], s72 offen nt lds
    s_xor_b32 s72, s72, 0x000e7000
    s_add_u32 m0, s75, 49152
    s_waitcnt vmcnt(4)
    ds_write_b32 v34, v27 offset:16
    buffer_load_dwordx4 v20, s[40:43], s72 offen nt lds
    s_xor_b32 s72, s72, 0x00021000
    s_add_u32 m0, s75, 53248
    s_waitcnt vmcnt(4)
    buffer_load_dwordx4 v20, s[40:43], s72 offen nt lds
    s_xor_b32 s72, s72, 0x00063000
    s_sub_u32 s72, s72, s75
    s_lshl_b32 s61, s3, 6
    s_add_u32 s72, s72, s61
    s_lshl_b32 s75, s3, 11
    s_add_u32 m0, s75, 57344
    s_waitcnt vmcnt(4)
    buffer_load_dwordx4 v21, s[40:43], s72 offen nt lds
    s_xor_b32 s72, s72, 0x00021000
    s_add_u32 m0, s75, 58368
    s_waitcnt vmcnt(4)
    buffer_load_dwordx4 v21, s[40:43], s72 offen nt lds
    s_waitcnt vmcnt(4)
    s_mov_b64 exec, 1
    ds_add_u32 v32, v27 offset:24
    s_mov_b64 exec, -1
    buffer_load_dwordx4 v[96:99], v121, s[44:47], s1 offen offset:0 nt
    s_mov_b32 s60, 0
L_vspin:
    ds_read_b32 v9, v32 offset:24
    s_add_u32 s60, s60, 1
    s_cmp_gt_u32 s60, 800000
    s_cbranch_scc1 L_vspin_x
    s_waitcnt lgkmcnt(0)
    v_cmp_ne_u32 vcc, 4, v9
    s_cbranch_vccnz L_vspin
L_vspin_x:
    ds_read_b64_tr_b16 v[68:69], v25 offset:0
    ds_read_b64_tr_b16 v[72:73], v26 offset:0
    ds_read_b64_tr_b16 v[70:71], v25 offset:4096
    ds_read_b64_tr_b16 v[74:75], v26 offset:4096
    ds_read_b64_tr_b16 v[76:77], v25 offset:8192
    ds_read_b64_tr_b16 v[80:81], v26 offset:8192
    ds_read_b64_tr_b16 v[78:79], v25 offset:12288
    ds_read_b64_tr_b16 v[82:83], v26 offset:12288
    s_add_u32 s58, s56, 1
    s_and_b32 s57, s58, s59
    v_mov_b32 v12, s57
    s_waitcnt vmcnt(4)
    buffer_load_dwordx4 v[100:103], v121, s[44:47], s1 offen offset:1024 nt
    s_waitcnt vmcnt(4)
    s_mov_b64 exec, 1
    ds_add_u32 v32, v27 offset:16
    s_mov_b64 exec, -1
    buffer_load_dwordx4 v[104:107], v121, s[44:47], s1 offen offset:2048 nt
    s_waitcnt vmcnt(4)
    buffer_load_dwordx4 v[108:111], v121, s[44:47], s1 offen offset:3072 nt
    s_mov_b32 s60, 0
L_pspin:
    ds_read_b64 v[8:9], v32 offset:16
L_padN2:
    s_cbranch_execz L_retN
    ds_read_b128 v[36:39], v31 offset:0
    ds_read_b128 v[40:43], v31 offset:256
    ds_read_b128 v[44:47], v31 offset:512
    ds_read_b128 v[48:51], v31 offset:768
    ds_read_b64_tr_b16 v[88:89], v25 offset:16384
    ds_read_b64_tr_b16 v[92:93], v26 offset:16384
    ds_read_b64_tr_b16 v[90:91], v25 offset:20480
    ds_read_b64_tr_b16 v[94:95], v26 offset:20480
    ds_read_b128 v[4:7], v35
    s_add_u32 s60, s60, 1
    s_cmp_gt_u32 s60, 800000
    s_cbranch_scc1 L_pspin_x
    s_waitcnt lgkmcnt(9)
    v_add_u32 v8, v8, v9
    v_cmp_ne_u32 vcc, 8, v8
    s_cbranch_vccz L_pspin_x
    s_waitcnt lgkmcnt(0)
    s_branch L_pspin
L_pspin_x:
    s_waitcnt lgkmcnt(8)
    v_mfma_f32_16x16x32_bf16 v[84:87], v[68:71], v[36:39], 0
    v_mfma_f32_16x16x32_bf16 v[56:59], v[72:75], v[36:39], 0
    s_waitcnt lgkmcnt(7)
    v_mfma_f32_16x16x32_bf16 v[84:87], v[76:79], v[40:43], v[84:87]
    v_mfma_f32_16x16x32_bf16 v[56:59], v[80:83], v[40:43], v[56:59]
    s_waitcnt lgkmcnt(1)
    v_mfma_f32_16x16x32_bf16 v[84:87], v[88:91], v[44:47], v[84:87]
    v_mfma_f32_16x16x32_bf16 v[56:59], v[92:95], v[44:47], v[56:59]
    s_waitcnt lgkmcnt(0)
    v_and_b32 v4, v4, v5
    v_and_b32 v6, v6, v7
    v_and_b32 v4, v4, v6
    s_nop 0
    v_readfirstlane_b32 s30, v4
    s_waitcnt vmcnt(5)
    ds_read_b64_tr_b16 v[60:61], v28 offset:24576
    ds_read_b64_tr_b16 v[64:65], v29 offset:24576
    s_waitcnt vmcnt(4)
    ds_read_b64_tr_b16 v[62:63], v28 offset:25600
    ds_read_b64_tr_b16 v[66:67], v29 offset:25600
    s_waitcnt lgkmcnt(1)
    v_mfma_f32_16x16x32_bf16 v[84:87], v[60:63], v[48:51], v[84:87]
    s_waitcnt lgkmcnt(0)
    v_mfma_f32_16x16x32_bf16 v[56:59], v[64:67], v[48:51], v[56:59]
    s_cmp_eq_u32 s30, 1
    s_nop 4
    v_bfi_b32 v84, s59, v12, v84
    v_bfi_b32 v85, s59, v12, v85
    v_bfi_b32 v86, s59, v12, v86
    v_bfi_b32 v87, s59, v12, v87
    s_mov_b64 exec, s[76:77]
    v_bfi_b32 v84, s59, v12, v56
    v_bfi_b32 v85, s59, v12, v57
    v_bfi_b32 v86, s59, v12, v58
    v_bfi_b32 v87, s59, v12, v59
    s_mov_b64 exec, s[78:79]
    s_cbranch_scc0 L_o_rem
    buffer_store_dwordx4 v[84:87], v33, s[52:55], s74 offen
L_o_done:
    s_mov_b64 exec, 1
    ds_add_u32 v32, v27 offset:36
    s_mov_b64 exec, -1
L_bospin:
    ds_read_b32 v9, v32 offset:36
    s_add_u32 s60, s60, 1
    s_cmp_gt_u32 s60, 800000
    s_cbranch_scc1 L_bospin_x
    s_waitcnt lgkmcnt(0)
    v_cmp_ne_u32 vcc, 4, v9
    s_cbranch_vccnz L_bospin
L_bospin_x:
    s_mov_b32 s62, 0
L_spoll:
    buffer_load_dwordx4 v[52:55], v120, s[52:55], s67 offen sc1 nt
    buffer_load_dwordx4 v[36:39], v3, s[52:55], s66 offen sc1 nt
    buffer_load_dwordx4 v[40:43], v3, s[52:55], s66 offen offset:1024 sc1 nt
    s_add_u32 s62, s62, 1
    s_cmp_gt_u32 s62, 100000
    s_cbranch_scc1 L_ogo
    s_waitcnt vmcnt(2)
    v_max_f32_dpp v9, v53, v53 quad_perm:[1,0,3,2] row_mask:0xf bank_mask:0xf
    v_cmp_ne_u32 s[70:71], s58, v52
    v_cmp_ne_u32 s[60:61], s58, v55
    v_max_f32_dpp v9, v9, v9 quad_perm:[2,3,0,1] row_mask:0xf bank_mask:0xf
    s_or_b64 s[70:71], s[70:71], s[60:61]
    s_waitcnt vmcnt(1)
    v_max_f32_dpp v9, v9, v9 row_half_mirror row_mask:0xf bank_mask:0xf
    v_xor_b32 v60, s57, v36
    v_xor_b32 v61, s57, v37
    v_max_f32_dpp v9, v9, v9 row_mirror row_mask:0xf bank_mask:0xf
    v_mov_b32 v10, v9
    v_xor_b32 v62, s57, v38
    v_xor_b32 v63, s57, v39
    v_permlane16_swap_b32 v9, v10
    s_waitcnt vmcnt(0)
    v_max_f32 v9, v9, v10
    v_xor_b32 v64, s57, v40
    v_sub_f32 v52, v53, v9
    v_xor_b32 v65, s57, v41
    v_exp_f32 v52, v52
    v_xor_b32 v66, s57, v42
    v_xor_b32 v67, s57, v43
    v_mul_f32 v12, v52, v54
    v_mov_b32 v14, v52
    v_or3_b32 v11, v60, v61, v62
    v_mov_b32 v13, v12
    v_or3_b32 v10, v63, v64, v65
    v_permlane16_swap_b32 v52, v14
    v_or3_b32 v11, v11, v66, v67
    v_permlane16_swap_b32 v12, v13
    v_or_b32 v11, v11, v10
    v_add_f32 v12, v12, v13
    v_and_b32 v11, s59, v11
    s_cmp_lg_u64 s[70:71], 0
    v_cmp_ne_u32 vcc, 0, v11
    s_cbranch_scc1 L_spoll
    s_cbranch_vccz L_ogo
L_opoll:
    s_mov_b64 exec, vcc
    buffer_load_dwordx4 v[36:39], v3, s[52:55], s66 offen sc1 nt
    buffer_load_dwordx4 v[40:43], v3, s[52:55], s66 offen offset:1024 sc1 nt
    s_mov_b64 exec, -1
    s_add_u32 s62, s62, 1
    s_cmp_gt_u32 s62, 100000
    s_cbranch_scc1 L_ogo
    s_waitcnt vmcnt(0)
    v_xor_b32 v60, s57, v36
    v_xor_b32 v61, s57, v37
    v_xor_b32 v62, s57, v38
    v_xor_b32 v63, s57, v39
    v_xor_b32 v64, s57, v40
    v_xor_b32 v65, s57, v41
    v_xor_b32 v66, s57, v42
    v_xor_b32 v67, s57, v43
    v_or3_b32 v9, v60, v61, v62
    v_or3_b32 v10, v63, v64, v65
    v_or3_b32 v9, v9, v66, v67
    v_or_b32 v9, v9, v10
    v_and_b32 v9, s59, v9
    v_cmp_ne_u32 vcc, 0, v9
    s_cbranch_vccnz L_opoll
L_ogo:
    v_mul_f32 v16, v52, v60
    v_mul_f32 v17, v52, v61
    v_mul_f32 v18, v52, v62
    v_mul_f32 v19, v52, v63
    v_fmac_f32 v16, v14, v64
    v_fmac_f32 v17, v14, v65
    v_fmac_f32 v18, v14, v66
    v_fmac_f32 v19, v14, v67
    v_add_f32_dpp v12, v12, v12 quad_perm:[1,0,3,2] row_mask:0xf bank_mask:0xf
    v_add_f32_dpp v16, v16, v16 quad_perm:[1,0,3,2] row_mask:0xf bank_mask:0xf
    v_add_f32_dpp v17, v17, v17 quad_perm:[1,0,3,2] row_mask:0xf bank_mask:0xf
    v_add_f32_dpp v18, v18, v18 quad_perm:[1,0,3,2] row_mask:0xf bank_mask:0xf
    v_add_f32_dpp v19, v19, v19 quad_perm:[1,0,3,2] row_mask:0xf bank_mask:0xf
    v_add_f32_dpp v12, v12, v12 quad_perm:[2,3,0,1] row_mask:0xf bank_mask:0xf
    v_add_f32_dpp v16, v16, v16 quad_perm:[2,3,0,1] row_mask:0xf bank_mask:0xf
    v_add_f32_dpp v17, v17, v17 quad_perm:[2,3,0,1] row_mask:0xf bank_mask:0xf
    v_add_f32_dpp v18, v18, v18 quad_perm:[2,3,0,1] row_mask:0xf bank_mask:0xf
    v_add_f32_dpp v19, v19, v19 quad_perm:[2,3,0,1] row_mask:0xf bank_mask:0xf
    v_add_f32_dpp v12, v12, v12 row_half_mirror row_mask:0xf bank_mask:0xf
    v_add_f32_dpp v16, v16, v16 row_half_mirror row_mask:0xf bank_mask:0xf
    v_add_f32_dpp v17, v17, v17 row_half_mirror row_mask:0xf bank_mask:0xf
    v_add_f32_dpp v18, v18, v18 row_half_mirror row_mask:0xf bank_mask:0xf
    v_add_f32_dpp v19, v19, v19 row_half_mirror row_mask:0xf bank_mask:0xf
    v_add_f32_dpp v12, v12, v12 row_mirror row_mask:0xf bank_mask:0xf
    v_rcp_f32 v13, v12
    v_add_f32_dpp v16, v16, v16 row_mirror row_mask:0xf bank_mask:0xf
    v_add_f32_dpp v17, v17, v17 row_mirror row_mask:0xf bank_mask:0xf
    v_add_f32_dpp v18, v18, v18 row_mirror row_mask:0xf bank_mask:0xf
    v_add_f32_dpp v19, v19, v19 row_mirror row_mask:0xf bank_mask:0xf
    v_mul_f32 v16, v16, v13
    v_mul_f32 v17, v17, v13
    v_mul_f32 v18, v18, v13
    v_mul_f32 v19, v19, v13
    v_cvt_pk_bf16_f32 v10, v16, v17
    v_cvt_pk_bf16_f32 v11, v18, v19
    v_perm_b32 v68, v10, v10, v112
    v_perm_b32 v69, v10, v10, v114
    v_perm_b32 v70, v10, v10, v116
    v_perm_b32 v71, v10, v10, v118
    v_perm_b32 v72, v10, v10, v113
L_padN3:
    s_cbranch_execz L_retN
    v_perm_b32 v73, v10, v10, v115
    v_perm_b32 v74, v10, v10, v117
    v_perm_b32 v75, v10, v10, v119
    v_mfma_f32_16x16x32_bf16 v[20:23], v[68:71], v[96:99], 0
    v_perm_b32 v76, v11, v11, v112
    v_perm_b32 v77, v11, v11, v114
    v_perm_b32 v78, v11, v11, v116
    v_perm_b32 v79, v11, v11, v118
    v_mfma_f32_16x16x32_bf16 v[20:23], v[72:75], v[100:103], v[20:23]
    v_perm_b32 v80, v11, v11, v113
    v_perm_b32 v81, v11, v11, v115
    v_perm_b32 v82, v11, v11, v117
    v_perm_b32 v83, v11, v11, v119
    v_mfma_f32_16x16x32_bf16 v[20:23], v[76:79], v[104:107], v[20:23]
    v_mov_b32 v13, s57
    s_mov_b32 s60, 0
    v_mfma_f32_16x16x32_bf16 v[20:23], v[80:83], v[108:111], v[20:23]
    s_mov_b32 s63, 0
    s_mov_b32 exec_hi, 0
    s_nop 5
    ds_write_b128 v122, v[20:23] offset:0
    s_mov_b64 exec, 1
    ds_add_u32 v32, v27 offset:40
    s_mov_b64 exec, -1
L_b3:
    ds_read_b32 v9, v32 offset:40
    ds_read_b128 v[16:19], v123 offset:0
    s_add_u32 s60, s60, 1
    s_cmp_gt_u32 s60, 800000
    s_cbranch_scc1 L_b3_x
    s_waitcnt lgkmcnt(0)
    v_cmp_ne_u32 vcc, 4, v9
    v_add_f32_dpp v16, v16, v16 quad_perm:[1,0,3,2] row_mask:0xf bank_mask:0xf
    v_add_f32_dpp v17, v17, v17 quad_perm:[1,0,3,2] row_mask:0xf bank_mask:0xf
    v_add_f32_dpp v18, v18, v18 quad_perm:[1,0,3,2] row_mask:0xf bank_mask:0xf
    v_add_f32_dpp v19, v19, v19 quad_perm:[1,0,3,2] row_mask:0xf bank_mask:0xf
    s_cbranch_vccnz L_b3
L_b3_x:
    v_add_f32_dpp v16, v16, v16 quad_perm:[2,3,0,1] row_mask:0xf bank_mask:0xf
    v_add_f32_dpp v17, v17, v17 quad_perm:[2,3,0,1] row_mask:0xf bank_mask:0xf
    v_add_f32_dpp v18, v18, v18 quad_perm:[2,3,0,1] row_mask:0xf bank_mask:0xf
    v_add_f32_dpp v19, v19, v19 quad_perm:[2,3,0,1] row_mask:0xf bank_mask:0xf
    s_mov_b64 exec, 0x11111111
    v_bfi_b32 v16, s59, v13, v16
    v_bfi_b32 v17, s59, v13, v17
    v_bfi_b32 v18, s59, v13, v18
    v_bfi_b32 v19, s59, v13, v19
    buffer_store_dwordx4 v[16:19], v124, s[52:55], s65 offen sc1
    s_mov_b64 exec, -1
    s_cmp_lg_u32 s3, 3
    s_cbranch_scc1 L_fin
    v_mov_b32 v2, 0
    s_bitcmp1_b32 s5, 0
    s_cselect_b64 s[70:71], -1, 0
    v_mov_b32 v13, s58
    ds_read_b128 v[28:31], v32 offset:64
L_ypoll:
    buffer_load_dwordx4 v[40:43], v126, s[52:55], s31 offen sc1
    s_add_u32 s63, s63, 1
L_yw:
    s_waitcnt vmcnt(0)
    buffer_load_dwordx4 v[24:27], v125, s[52:55], s68 offen sc1
L_yc:
    v_xor_b32 v36, s57, v40
    v_xor_b32 v37, s57, v41
    v_xor_b32 v38, s57, v42
    v_xor_b32 v39, s57, v43
    v_or3_b32 v9, v36, v37, v38
    v_or_b32 v9, v9, v39
    v_and_b32 v9, s59, v9
    v_cmp_ne_u32 vcc, 0, v9
    v_cndmask_b32 v16, v36, v38, s[70:71]
    v_cndmask_b32 v17, v37, v39, s[70:71]
    s_cmp_gt_u32 s63, 100000
    s_cbranch_scc1 L_ygo
    s_cbranch_vccnz L_ypoll
L_ygo:
    v_add_f32_dpp v16, v16, v16 quad_perm:[1,0,3,2] row_mask:0xf bank_mask:0xf
    v_add_f32_dpp v17, v17, v17 quad_perm:[1,0,3,2] row_mask:0xf bank_mask:0xf
    s_nop 0
    v_add_f32_dpp v16, v16, v16 quad_perm:[2,3,0,1] row_mask:0xf bank_mask:0xf
    v_add_f32_dpp v17, v17, v17 quad_perm:[2,3,0,1] row_mask:0xf bank_mask:0xf
    s_nop 0
    v_add_f32_dpp v16, v16, v16 row_half_mirror row_mask:0xf bank_mask:0xf
    v_add_f32_dpp v17, v17, v17 row_half_mirror row_mask:0xf bank_mask:0xf
    s_nop 0
    v_add_f32_dpp v16, v16, v16 row_mirror row_mask:0xf bank_mask:0xf
    v_add_f32_dpp v17, v17, v17 row_mirror row_mask:0xf bank_mask:0xf
    s_nop 0
    v_add_f32_dpp v16, v16, v16 row_bcast:15 row_mask:0xa bank_mask:0xf
    v_add_f32_dpp v17, v17, v17 row_bcast:15 row_mask:0xa bank_mask:0xf
    s_waitcnt lgkmcnt(0)
    v_cvt_pk_bf16_f32 v18, v16, v17
    v_lshlrev_b32 v16, 16, v18
    v_and_b32 v17, s34, v18
    v_add_f32 v16, v28, v16
    v_add_f32 v17, v28, v17
    v_cvt_pk_bf16_f32 v18, v16, v17
    v_lshlrev_b32 v16, 16, v18
    v_and_b32 v17, s34, v18
    v_mul_f32 v18, 0xbfb8aa3b, v16
    v_mul_f32 v19, 0xbfb8aa3b, v17
    v_exp_f32 v18, v18
    v_exp_f32 v19, v19
    v_add_f32 v18, 1.0, v18
    v_add_f32 v19, 1.0, v19
    v_rcp_f32 v18, v18
    v_rcp_f32 v19, v19
    v_mul_f32 v16, v16, v18
    v_mul_f32 v17, v17, v19
    v_cvt_pk_bf16_f32 v18, v16, v17
    v_lshlrev_b32 v28, 16, v18
    v_and_b32 v29, s34, v18
L_fpoll:
    s_waitcnt vmcnt(0)
    v_xor_b32 v36, s57, v24
    v_xor_b32 v37, s57, v25
    v_xor_b32 v38, s57, v26
    v_xor_b32 v39, s57, v27
    v_or3_b32 v9, v36, v37, v38
    v_or_b32 v9, v9, v39
    v_and_b32 v9, s59, v9
    v_cmp_ne_u32 vcc, 0, v9
    v_cndmask_b32 v20, v36, v38, s[70:71]
    v_cndmask_b32 v21, v37, v39, s[70:71]
    s_cbranch_vccz L_fgo
    s_mov_b64 exec, vcc
    buffer_load_dwordx4 v[24:27], v125, s[52:55], s68 offen sc1
    s_mov_b64 exec, -1
    s_add_u32 s63, s63, 1
    s_cmp_le_u32 s63, 100000
    s_cbranch_scc1 L_fpoll
L_fgo:
    v_add_f32_dpp v20, v20, v20 quad_perm:[1,0,3,2] row_mask:0xf bank_mask:0xf
    v_add_f32_dpp v21, v21, v21 quad_perm:[1,0,3,2] row_mask:0xf bank_mask:0xf
    s_nop 0
    v_add_f32_dpp v20, v20, v20 quad_perm:[2,3,0,1] row_mask:0xf bank_mask:0xf
    v_add_f32_dpp v21, v21, v21 quad_perm:[2,3,0,1] row_mask:0xf bank_mask:0xf
    s_nop 0
    v_add_f32_dpp v20, v20, v20 row_half_mirror row_mask:0xf bank_mask:0xf
    v_add_f32_dpp v21, v21, v21 row_half_mirror row_mask:0xf bank_mask:0xf
    s_nop 0
    v_add_f32_dpp v20, v20, v20 row_mirror row_mask:0xf bank_mask:0xf
    v_add_f32_dpp v21, v21, v21 row_mirror row_mask:0xf bank_mask:0xf
    s_nop 0
    v_add_f32_dpp v20, v20, v20 row_bcast:15 row_mask:0xa bank_mask:0xf
    v_add_f32_dpp v21, v21, v21 row_bcast:15 row_mask:0xa bank_mask:0xf
    s_nop 0
    v_add_f32_dpp v20, v20, v20 row_bcast:31 row_mask:0xc bank_mask:0xf
    v_add_f32_dpp v21, v21, v21 row_bcast:31 row_mask:0xc bank_mask:0xf
    v_cvt_pk_bf16_f32 v18, v20, v21
    v_lshlrev_b32 v20, 16, v18
    v_and_b32 v21, s34, v18
    v_mul_f32 v20, v20, v28
    v_mul_f32 v21, v21, v29
    v_cvt_pk_bf16_f32 v18, v20, v21
    v_lshlrev_b32 v20, 16, v18
    v_and_b32 v21, s34, v18
    v_add_f32 v20, v30, v20
    v_add_f32 v21, v31, v21
    s_mov_b32 exec_lo, 0
    s_mov_b32 exec_hi, 0x80000000
    v_cvt_pk_bf16_f32 v18, v20, v21
    buffer_store_dword v18, v2, s[48:51], s69 offen
    s_cmp_lg_u32 s2, 0
    s_cbranch_scc1 L_noep
    buffer_store_dword v13, v2, s[52:55], 0 offen
L_noep:
    s_mov_b64 exec, -1
L_fin:
L_end:
    s_endpgm
L_st_rem:
    buffer_store_dwordx4 v[8:11], v6, s[52:55], s75 offen sc1
    s_branch L_st_done
L_o_rem:
    buffer_store_dwordx4 v[84:87], v33, s[52:55], s74 offen sc1
    s_branch L_o_done
L_codeend:

.section .rodata,"a"
.p2align 6
.amdhsa_kernel recurrent_scan__sliding_block_cached__mixer_token_mlp__decode_kernel
  .amdhsa_next_free_vgpr 128
  .amdhsa_next_free_sgpr 102
  .amdhsa_accum_offset 128
  .amdhsa_group_segment_fixed_size 0
  .amdhsa_kernarg_size 104
  .amdhsa_user_sgpr_count 2
  .amdhsa_user_sgpr_kernarg_segment_ptr 1
  .amdhsa_system_sgpr_workgroup_id_x 1
.end_amdhsa_kernel
```
